```python
import torch

def _softmax(x, axis=-1):
    return torch.softmax(x, dim=axis)
def _gelu(x):
    return torch.nn.functional.gelu(x, approximate="tanh")
def _silu(x):
    return torch.nn.functional.silu(x)
def _sigmoid(x):
    return torch.sigmoid(x)
def _layernorm(x, axis=-1, eps=1e-5):
    m = x.mean(dim=axis, keepdim=True)
    v = x.var(dim=axis, keepdim=True, unbiased=False)
    return (x - m) / torch.sqrt(v + eps)
def _scatter_add(tgt, idx, src, axis=0):
    return tgt.clone().index_add_(axis, idx, src)
def _segment_sum(src, seg, n):
    out = torch.zeros((n,) + src.shape[1:], dtype=src.dtype)
    return out.index_add_(0, seg, src)
def _pad(x, pw):
    flat = tuple(v for pair in reversed(pw) for v in pair)
    return torch.nn.functional.pad(x, flat)

kernel_name = 'standalone__softmax_full_bidir__decode'

def setup_inputs():

    _w = (lambda a: (lambda t: t.to(torch.bfloat16) if t.is_floating_point() else t)(torch.as_tensor(a)))
    B, H, Sq, Skv, Dh = 1, 32, 1, 4096, 128
    return {
        "q": _w((lambda *s: torch.randn(*s, dtype=torch.bfloat16) * 0.8)(B, H, Sq, Dh)),
        "k": _w((lambda *s: torch.randn(*s, dtype=torch.bfloat16) * 0.8)(B, H, Skv, Dh)),
        "v": _w((lambda *s: torch.randn(*s, dtype=torch.bfloat16) * 0.05)(B, H, Skv, Dh)),
    }

def reference(q, k, v):
    scale = q.shape[-1] ** -0.5
    scores = torch.einsum('bhqd,bhkd->bhqk', q, k) * scale
    attn = _softmax(scores, axis=-1)
    return torch.einsum('bhqk,bhkd->bhqd', attn, v)
```

```asm
; @launch grid=(256,1,1) block=(320,1,1) lds=98304
.amdgcn_target "amdgcn-amd-amdhsa--gfx950"
.text
.globl standalone__softmax_full_bidir__decode_kernel
.p2align 8
.type standalone__softmax_full_bidir__decode_kernel,@function
standalone__softmax_full_bidir__decode_kernel:
  s_load_dwordx2 s[8:9], s[0:1], 8
  s_load_dwordx2 s[16:17], s[0:1], 0
  s_load_dwordx2 s[12:13], s[0:1], 16
  v_readfirstlane_b32 s3, v0
  s_cmpk_ge_u32 s2, 0x100
  s_cbranch_scc1 L_exit
  s_cmpk_lt_u32 s3, 0x100
  s_cbranch_scc1 L_common
  s_getpc_b64 s[28:29]
  v_lshlrev_b32 v2, 6, v0
  v_and_b32 v2, 0xfc0, v2
  global_load_dword v15, v2, s[28:29]
  global_load_dword v14, v2, s[28:29] offset:1024
L_common:
  s_and_b32 s4, s2, 7
  s_bfe_u32 s5, s2, 0x20003
  s_lshl2_add_u32 s4, s4, s5
  s_lshr_b32 s5, s2, 5
  s_lshl_b32 s6, s4, 20
  s_lshl_b32 s7, s5, 17
  s_add_u32 s6, s6, s7
  s_cmpk_ge_u32 s3, 0x100
  s_cbranch_scc1 L_helper
  s_brev_b32 s10, 64
  s_mov_b32 s11, 0x20000
  v_and_b32 v10, 3, v0
  v_lshlrev_b32 v10, 4, v10
  v_bfe_u32 v11, v0, 4, 2
  v_lshl_add_u32 v10, v11, 6, v10
  v_bfe_u32 v11, v0, 2, 2
  v_lshl_add_u32 v1, v11, 8, v10
  s_lshl4_add_u32 s32, s3, s6
  s_movk_i32 s31, 0x1000
  s_add_u32 s33, s32, s31
  s_add_u32 s34, s33, s31
  s_add_u32 s35, s34, s31
  s_add_u32 s36, s35, s31
  s_add_u32 s37, s36, s31
  s_add_u32 s38, s37, s31
  s_add_u32 s39, s38, s31
  s_add_u32 s40, s39, s31
  s_add_u32 s41, s40, s31
  s_add_u32 s42, s41, s31
  s_add_u32 s43, s42, s31
  s_add_u32 s44, s43, s31
  s_add_u32 s45, s44, s31
  s_add_u32 s46, s45, s31
  s_add_u32 s47, s46, s31
  s_add_u32 s48, s47, s31
  s_add_u32 s49, s48, s31
  s_add_u32 s50, s49, s31
  s_add_u32 s51, s50, s31
  s_add_u32 s52, s51, s31
  s_add_u32 s53, s52, s31
  s_add_u32 s54, s53, s31
  s_add_u32 s55, s54, s31
  s_add_u32 s56, s55, s31
  s_add_u32 s57, s56, s31
  s_add_u32 s58, s57, s31
  s_add_u32 s59, s58, s31
  s_add_u32 s60, s59, s31
  s_add_u32 s61, s60, s31
  s_add_u32 s62, s61, s31
  s_add_u32 s63, s62, s31
  v_lshl_add_u32 v3, v11, 16, v10
  v_subrev_u32 v4, 0x10000, v3
  v_subrev_u32 v5, 0x20000, v3
  v_subrev_u32 v6, 0x30000, v3
  s_movk_i32 s18, 0x2000
  s_mov_b32 s19, s11
  s_lshl_b32 s7, s4, 8
  s_waitcnt lgkmcnt(0)
  buffer_load_dwordx4 v[32:35], v1, s[8:11], s32 offen nt
  buffer_load_dwordx4 v[36:39], v1, s[8:11], s33 offen nt
  buffer_load_dwordx4 v[40:43], v1, s[8:11], s34 offen nt
  buffer_load_dwordx4 v[44:47], v1, s[8:11], s35 offen nt
  buffer_load_dwordx4 v[16:19], v3, s[16:19], s7 offen
  buffer_load_dwordx4 v[20:23], v4, s[16:19], s7 offen
  buffer_load_dwordx4 v[24:27], v5, s[16:19], s7 offen
  buffer_load_dwordx4 v[28:31], v6, s[16:19], s7 offen
  buffer_load_dwordx4 v[48:51], v1, s[8:11], s36 offen nt
  buffer_load_dwordx4 v[52:55], v1, s[8:11], s37 offen nt
  buffer_load_dwordx4 v[56:59], v1, s[8:11], s38 offen nt
  buffer_load_dwordx4 v[60:63], v1, s[8:11], s39 offen nt
  buffer_load_dwordx4 v[64:67], v1, s[8:11], s40 offen nt
  buffer_load_dwordx4 v[68:71], v1, s[8:11], s41 offen nt
  buffer_load_dwordx4 v[72:75], v1, s[8:11], s42 offen nt
  buffer_load_dwordx4 v[76:79], v1, s[8:11], s43 offen nt
  buffer_load_dwordx4 v[80:83], v1, s[8:11], s44 offen nt
  buffer_load_dwordx4 v[84:87], v1, s[8:11], s45 offen nt
  buffer_load_dwordx4 v[88:91], v1, s[8:11], s46 offen nt
  buffer_load_dwordx4 v[92:95], v1, s[8:11], s47 offen nt
  s_mov_b32 s14, s10
  s_mov_b32 s15, s11
  v_and_b32 v2, 63, v0
  v_lshlrev_b32 v2, 4, v2
  v_mov_b64 v[200:201], 0
  v_mov_b64 v[202:203], 0
  v_mov_b32 v9, 0x3e0293ee
  v_and_b32 v10, 2, v0
  v_cmp_ne_u32 vcc, 0, v10
  v_mov_b32 v12, 0xffff0000
  v_and_b32 v10, 1, v0
  v_cndmask_b32 v7, 0, v12, vcc
  v_cmp_ne_u32 vcc, 0, v10
  v_mov_b32 v12, 0x03020c0c
  v_mov_b32 v10, 0x0c0c0302
  v_cndmask_b32 v8, v10, v12, vcc
  v_lshlrev_b32 v13, 3, v0
  v_lshrrev_b32 v14, 3, v0
  v_and_b32 v14, 24, v14
  s_waitcnt vmcnt(12)
  v_mfma_f32_16x16x32_bf16 v[160:163], v[32:35], v[16:19], 0
  buffer_load_dwordx4 v[96:99], v1, s[8:11], s48 offen nt
  v_mfma_f32_16x16x32_bf16 v[160:163], v[36:39], v[20:23], v[160:163]
  buffer_load_dwordx4 v[100:103], v1, s[8:11], s49 offen nt
  v_mfma_f32_16x16x32_bf16 v[160:163], v[40:43], v[24:27], v[160:163]
  buffer_load_dwordx4 v[104:107], v1, s[8:11], s50 offen nt
  v_mfma_f32_16x16x32_bf16 v[160:163], v[44:47], v[28:31], v[160:163]
  buffer_load_dwordx4 v[108:111], v1, s[8:11], s51 offen nt
  s_waitcnt vmcnt(15)
  v_mfma_f32_16x16x32_bf16 v[164:167], v[48:51], v[16:19], 0
  buffer_load_dwordx4 v[112:115], v1, s[8:11], s52 offen nt
  s_waitcnt vmcnt(15)
  v_mfma_f32_16x16x32_bf16 v[164:167], v[52:55], v[20:23], v[164:167]
  buffer_load_dwordx4 v[116:119], v1, s[8:11], s53 offen nt
  s_waitcnt vmcnt(15)
  v_mfma_f32_16x16x32_bf16 v[164:167], v[56:59], v[24:27], v[164:167]
  buffer_load_dwordx4 v[120:123], v1, s[8:11], s54 offen nt
  s_waitcnt vmcnt(15)
  v_mfma_f32_16x16x32_bf16 v[164:167], v[60:63], v[28:31], v[164:167]
  buffer_load_dwordx4 v[124:127], v1, s[8:11], s55 offen nt
  s_waitcnt vmcnt(15)
  v_mfma_f32_16x16x32_bf16 v[168:171], v[64:67], v[16:19], 0
  buffer_load_dwordx4 v[128:131], v1, s[8:11], s56 offen nt
  s_waitcnt vmcnt(15)
  v_mfma_f32_16x16x32_bf16 v[168:171], v[68:71], v[20:23], v[168:171]
  buffer_load_dwordx4 v[132:135], v1, s[8:11], s57 offen nt
  s_waitcnt vmcnt(15)
  v_mfma_f32_16x16x32_bf16 v[168:171], v[72:75], v[24:27], v[168:171]
  buffer_load_dwordx4 v[136:139], v1, s[8:11], s58 offen nt
  s_waitcnt vmcnt(15)
  v_mfma_f32_16x16x32_bf16 v[168:171], v[76:79], v[28:31], v[168:171]
  buffer_load_dwordx4 v[140:143], v1, s[8:11], s59 offen nt
  s_waitcnt vmcnt(15)
  v_mfma_f32_16x16x32_bf16 v[172:175], v[80:83], v[16:19], 0
  buffer_load_dwordx4 v[144:147], v1, s[8:11], s60 offen nt
  s_waitcnt vmcnt(15)
  v_mfma_f32_16x16x32_bf16 v[172:175], v[84:87], v[20:23], v[172:175]
  buffer_load_dwordx4 v[148:151], v1, s[8:11], s61 offen nt
  s_waitcnt vmcnt(15)
  v_mfma_f32_16x16x32_bf16 v[172:175], v[88:91], v[24:27], v[172:175]
  buffer_load_dwordx4 v[152:155], v1, s[8:11], s62 offen nt
  s_waitcnt vmcnt(15)
  v_mfma_f32_16x16x32_bf16 v[172:175], v[92:95], v[28:31], v[172:175]
  buffer_load_dwordx4 v[156:159], v1, s[8:11], s63 offen nt
  s_waitcnt vmcnt(15)
  v_mfma_f32_16x16x32_bf16 v[176:179], v[96:99], v[16:19], 0
  buffer_load_dwordx4 v[32:35], v2, s[12:15], s32 offen nt
  s_waitcnt vmcnt(15)
  v_mfma_f32_16x16x32_bf16 v[176:179], v[100:103], v[20:23], v[176:179]
  buffer_load_dwordx4 v[36:39], v2, s[12:15], s33 offen nt
  s_waitcnt vmcnt(15)
  v_mfma_f32_16x16x32_bf16 v[176:179], v[104:107], v[24:27], v[176:179]
  buffer_load_dwordx4 v[40:43], v2, s[12:15], s34 offen nt
  s_waitcnt vmcnt(15)
  v_mfma_f32_16x16x32_bf16 v[176:179], v[108:111], v[28:31], v[176:179]
  buffer_load_dwordx4 v[44:47], v2, s[12:15], s35 offen nt
  s_waitcnt vmcnt(15)
  v_mfma_f32_16x16x32_bf16 v[180:183], v[112:115], v[16:19], 0
  buffer_load_dwordx4 v[48:51], v2, s[12:15], s36 offen nt
  s_waitcnt vmcnt(15)
  v_mfma_f32_16x16x32_bf16 v[180:183], v[116:119], v[20:23], v[180:183]
  buffer_load_dwordx4 v[52:55], v2, s[12:15], s37 offen nt
  s_waitcnt vmcnt(15)
  v_mfma_f32_16x16x32_bf16 v[180:183], v[120:123], v[24:27], v[180:183]
  buffer_load_dwordx4 v[56:59], v2, s[12:15], s38 offen nt
  s_waitcnt vmcnt(15)
  v_mfma_f32_16x16x32_bf16 v[180:183], v[124:127], v[28:31], v[180:183]
  buffer_load_dwordx4 v[60:63], v2, s[12:15], s39 offen nt
  s_waitcnt vmcnt(15)
  v_mfma_f32_16x16x32_bf16 v[184:187], v[128:131], v[16:19], 0
  buffer_load_dwordx4 v[64:67], v2, s[12:15], s40 offen nt
  s_waitcnt vmcnt(15)
  v_mfma_f32_16x16x32_bf16 v[184:187], v[132:135], v[20:23], v[184:187]
  buffer_load_dwordx4 v[68:71], v2, s[12:15], s41 offen nt
  s_waitcnt vmcnt(15)
  v_mfma_f32_16x16x32_bf16 v[184:187], v[136:139], v[24:27], v[184:187]
  buffer_load_dwordx4 v[72:75], v2, s[12:15], s42 offen nt
  s_waitcnt vmcnt(15)
  v_mfma_f32_16x16x32_bf16 v[184:187], v[140:143], v[28:31], v[184:187]
  buffer_load_dwordx4 v[76:79], v2, s[12:15], s43 offen nt
  s_waitcnt vmcnt(15)
  v_mfma_f32_16x16x32_bf16 v[188:191], v[144:147], v[16:19], 0
  buffer_load_dwordx4 v[80:83], v2, s[12:15], s44 offen nt
  s_waitcnt vmcnt(15)
  v_mfma_f32_16x16x32_bf16 v[188:191], v[148:151], v[20:23], v[188:191]
  buffer_load_dwordx4 v[84:87], v2, s[12:15], s45 offen nt
  s_waitcnt vmcnt(15)
  v_mfma_f32_16x16x32_bf16 v[188:191], v[152:155], v[24:27], v[188:191]
  buffer_load_dwordx4 v[88:91], v2, s[12:15], s46 offen nt
  s_waitcnt vmcnt(15)
  v_mfma_f32_16x16x32_bf16 v[188:191], v[156:159], v[28:31], v[188:191]
  buffer_load_dwordx4 v[92:95], v2, s[12:15], s47 offen nt
  v_add_f32_dpp v161, v160, v161 quad_perm:[0,0,0,0] row_mask:0xf bank_mask:0xf
  v_add_f32_dpp v163, v162, v163 quad_perm:[2,2,2,2] row_mask:0xf bank_mask:0xf
  v_add_f32_dpp v165, v164, v165 quad_perm:[0,0,0,0] row_mask:0xf bank_mask:0xf
  v_add_f32_dpp v167, v166, v167 quad_perm:[2,2,2,2] row_mask:0xf bank_mask:0xf
  v_add_f32_dpp v169, v168, v169 quad_perm:[0,0,0,0] row_mask:0xf bank_mask:0xf
  v_add_f32_dpp v171, v170, v171 quad_perm:[2,2,2,2] row_mask:0xf bank_mask:0xf
  v_add_f32_dpp v173, v172, v173 quad_perm:[0,0,0,0] row_mask:0xf bank_mask:0xf
  v_add_f32_dpp v175, v174, v175 quad_perm:[2,2,2,2] row_mask:0xf bank_mask:0xf
  v_add_f32_dpp v177, v176, v177 quad_perm:[0,0,0,0] row_mask:0xf bank_mask:0xf
  v_add_f32_dpp v179, v178, v179 quad_perm:[2,2,2,2] row_mask:0xf bank_mask:0xf
  v_add_f32_dpp v181, v180, v181 quad_perm:[0,0,0,0] row_mask:0xf bank_mask:0xf
  v_add_f32_dpp v183, v182, v183 quad_perm:[2,2,2,2] row_mask:0xf bank_mask:0xf
  v_add_f32_dpp v185, v184, v185 quad_perm:[0,0,0,0] row_mask:0xf bank_mask:0xf
  v_add_f32_dpp v187, v186, v187 quad_perm:[2,2,2,2] row_mask:0xf bank_mask:0xf
  v_add_f32_dpp v189, v188, v189 quad_perm:[0,0,0,0] row_mask:0xf bank_mask:0xf
  v_add_f32_dpp v191, v190, v191 quad_perm:[2,2,2,2] row_mask:0xf bank_mask:0xf
  v_add_f32_dpp v163, v161, v163 quad_perm:[1,1,1,1] row_mask:0xf bank_mask:0xf
  v_add_f32_dpp v167, v165, v167 quad_perm:[1,1,1,1] row_mask:0xf bank_mask:0xf
  v_add_f32_dpp v171, v169, v171 quad_perm:[1,1,1,1] row_mask:0xf bank_mask:0xf
  v_add_f32_dpp v175, v173, v175 quad_perm:[1,1,1,1] row_mask:0xf bank_mask:0xf
  v_add_f32_dpp v179, v177, v179 quad_perm:[1,1,1,1] row_mask:0xf bank_mask:0xf
  v_add_f32_dpp v183, v181, v183 quad_perm:[1,1,1,1] row_mask:0xf bank_mask:0xf
  v_add_f32_dpp v187, v185, v187 quad_perm:[1,1,1,1] row_mask:0xf bank_mask:0xf
  v_add_f32_dpp v191, v189, v191 quad_perm:[1,1,1,1] row_mask:0xf bank_mask:0xf
  v_mul_f32_dpp v192, v163, v9 quad_perm:[3,3,3,3] row_mask:0xf bank_mask:0xf
  v_mul_f32_dpp v193, v167, v9 quad_perm:[3,3,3,3] row_mask:0xf bank_mask:0xf
  v_mul_f32_dpp v194, v171, v9 quad_perm:[3,3,3,3] row_mask:0xf bank_mask:0xf
  v_mul_f32_dpp v195, v175, v9 quad_perm:[3,3,3,3] row_mask:0xf bank_mask:0xf
  v_mul_f32_dpp v196, v179, v9 quad_perm:[3,3,3,3] row_mask:0xf bank_mask:0xf
  v_mul_f32_dpp v197, v183, v9 quad_perm:[3,3,3,3] row_mask:0xf bank_mask:0xf
  v_mul_f32_dpp v198, v187, v9 quad_perm:[3,3,3,3] row_mask:0xf bank_mask:0xf
  v_mul_f32_dpp v199, v191, v9 quad_perm:[3,3,3,3] row_mask:0xf bank_mask:0xf
  v_max3_f32 v208, v192, v193, v194
  v_max3_f32 v208, v208, v195, v196
  v_max3_f32 v208, v208, v197, v198
  v_max_f32 v208, v208, v199
  s_nop 1
  v_max_f32_dpp v208, v208, v208 row_ror:4 row_mask:0xf bank_mask:0xf
  s_nop 1
  v_max_f32_dpp v208, v208, v208 row_ror:8 row_mask:0xf bank_mask:0xf
  s_nop 1
  v_max_f32_dpp v208, v208, v208 row_bcast:15 row_mask:0xa bank_mask:0xf
  s_nop 1
  v_max_f32_dpp v208, v208, v208 row_bcast:31 row_mask:0xc bank_mask:0xf
  s_nop 0
  v_readlane_b32 s6, v208, 63
  s_nop 1
  v_subrev_f32 v192, s6, v192
  v_subrev_f32 v193, s6, v193
  v_subrev_f32 v194, s6, v194
  v_subrev_f32 v195, s6, v195
  v_subrev_f32 v196, s6, v196
  v_subrev_f32 v197, s6, v197
  v_subrev_f32 v198, s6, v198
  v_subrev_f32 v199, s6, v199
  v_exp_f32 v192, v192
  v_exp_f32 v193, v193
  v_exp_f32 v194, v194
  v_exp_f32 v195, v195
  v_exp_f32 v196, v196
  v_exp_f32 v197, v197
  v_exp_f32 v198, v198
  v_exp_f32 v199, v199
  v_add_f32 v209, v192, v193
  v_add_f32 v209, v209, v194
  v_add_f32 v209, v209, v195
  v_add_f32 v209, v209, v196
  v_add_f32 v209, v209, v197
  v_add_f32 v209, v209, v198
  v_add_f32 v209, v209, v199
  v_and_b32 v160, v192, v7
  v_sub_f32 v160, v192, v160
  v_perm_b32 v192, v160, v160, v8
  v_add_f32_dpp v209, v209, v209 row_ror:4 row_mask:0xf bank_mask:0xf
  v_and_b32 v161, v193, v7
  v_sub_f32 v161, v193, v161
  v_perm_b32 v193, v161, v161, v8
  v_add_f32_dpp v209, v209, v209 row_ror:8 row_mask:0xf bank_mask:0xf
  v_and_b32 v162, v194, v7
  v_sub_f32 v162, v194, v162
  v_perm_b32 v194, v162, v162, v8
  v_add_f32_dpp v209, v209, v209 row_bcast:15 row_mask:0xa bank_mask:0xf
  v_and_b32 v163, v195, v7
  v_sub_f32 v163, v195, v163
  v_perm_b32 v195, v163, v163, v8
  v_add_f32_dpp v209, v209, v209 row_bcast:31 row_mask:0xc bank_mask:0xf
  v_and_b32 v164, v196, v7
  v_sub_f32 v164, v196, v164
  v_perm_b32 v196, v164, v164, v8
  v_and_b32 v165, v197, v7
  v_sub_f32 v165, v197, v165
  v_perm_b32 v197, v165, v165, v8
  v_and_b32 v166, v198, v7
  v_sub_f32 v166, v198, v166
  v_perm_b32 v198, v166, v166, v8
  v_and_b32 v167, v199, v7
  v_sub_f32 v167, v199, v167
  v_perm_b32 v199, v167, v167, v8
  s_lshl_b64 exec, 1, 63
  ds_write_b64 v14, v[208:209] offset:2048
  s_mov_b64 exec, -1
  v_mov_b32_dpp v200, v192 quad_perm:[0,1,2,3] row_mask:0xf bank_mask:0x1
  v_mov_b32_dpp v201, v192 row_ror:4 row_mask:0xf bank_mask:0x2
  v_mov_b32_dpp v202, v192 row_ror:8 row_mask:0xf bank_mask:0x4
  v_mov_b32_dpp v203, v192 row_ror:12 row_mask:0xf bank_mask:0x8
  s_nop 0
  s_waitcnt vmcnt(15)
  v_mfma_f32_16x16x32_bf16 v[204:207], v[200:203], v[32:35], 0
  buffer_load_dwordx4 v[96:99], v2, s[12:15], s48 offen nt
  v_mov_b32_dpp v200, v192 row_ror:12 row_mask:0xf bank_mask:0x1
  v_mov_b32_dpp v201, v192 quad_perm:[0,1,2,3] row_mask:0xf bank_mask:0x2
  v_mov_b32_dpp v202, v192 row_ror:4 row_mask:0xf bank_mask:0x4
  v_mov_b32_dpp v203, v192 row_ror:8 row_mask:0xf bank_mask:0x8
  s_nop 0
  s_waitcnt vmcnt(15)
  v_mfma_f32_16x16x32_bf16 v[204:207], v[200:203], v[36:39], v[204:207]
  buffer_load_dwordx4 v[100:103], v2, s[12:15], s49 offen nt
  v_mov_b32_dpp v200, v192 row_ror:8 row_mask:0xf bank_mask:0x1
  v_mov_b32_dpp v201, v192 row_ror:12 row_mask:0xf bank_mask:0x2
  v_mov_b32_dpp v202, v192 quad_perm:[0,1,2,3] row_mask:0xf bank_mask:0x4
  v_mov_b32_dpp v203, v192 row_ror:4 row_mask:0xf bank_mask:0x8
  s_nop 0
  s_waitcnt vmcnt(15)
  v_mfma_f32_16x16x32_bf16 v[204:207], v[200:203], v[40:43], v[204:207]
  buffer_load_dwordx4 v[104:107], v2, s[12:15], s50 offen nt
  v_mov_b32_dpp v200, v192 row_ror:4 row_mask:0xf bank_mask:0x1
  v_mov_b32_dpp v201, v192 row_ror:8 row_mask:0xf bank_mask:0x2
  v_mov_b32_dpp v202, v192 row_ror:12 row_mask:0xf bank_mask:0x4
  v_mov_b32_dpp v203, v192 quad_perm:[0,1,2,3] row_mask:0xf bank_mask:0x8
  s_nop 0
  s_waitcnt vmcnt(15)
  v_mfma_f32_16x16x32_bf16 v[204:207], v[200:203], v[44:47], v[204:207]
  buffer_load_dwordx4 v[108:111], v2, s[12:15], s51 offen nt
  v_mov_b32_dpp v200, v193 quad_perm:[0,1,2,3] row_mask:0xf bank_mask:0x1
  v_mov_b32_dpp v201, v193 row_ror:4 row_mask:0xf bank_mask:0x2
  v_mov_b32_dpp v202, v193 row_ror:8 row_mask:0xf bank_mask:0x4
  v_mov_b32_dpp v203, v193 row_ror:12 row_mask:0xf bank_mask:0x8
  s_nop 0
  s_waitcnt vmcnt(15)
  v_mfma_f32_16x16x32_bf16 v[204:207], v[200:203], v[48:51], v[204:207]
  buffer_load_dwordx4 v[112:115], v2, s[12:15], s52 offen nt
  v_mov_b32_dpp v200, v193 row_ror:12 row_mask:0xf bank_mask:0x1
  v_mov_b32_dpp v201, v193 quad_perm:[0,1,2,3] row_mask:0xf bank_mask:0x2
  v_mov_b32_dpp v202, v193 row_ror:4 row_mask:0xf bank_mask:0x4
  v_mov_b32_dpp v203, v193 row_ror:8 row_mask:0xf bank_mask:0x8
  s_nop 0
  s_waitcnt vmcnt(15)
  v_mfma_f32_16x16x32_bf16 v[204:207], v[200:203], v[52:55], v[204:207]
  buffer_load_dwordx4 v[116:119], v2, s[12:15], s53 offen nt
  v_mov_b32_dpp v200, v193 row_ror:8 row_mask:0xf bank_mask:0x1
  v_mov_b32_dpp v201, v193 row_ror:12 row_mask:0xf bank_mask:0x2
  v_mov_b32_dpp v202, v193 quad_perm:[0,1,2,3] row_mask:0xf bank_mask:0x4
  v_mov_b32_dpp v203, v193 row_ror:4 row_mask:0xf bank_mask:0x8
  s_nop 0
  s_waitcnt vmcnt(15)
  v_mfma_f32_16x16x32_bf16 v[204:207], v[200:203], v[56:59], v[204:207]
  buffer_load_dwordx4 v[120:123], v2, s[12:15], s54 offen nt
  v_mov_b32_dpp v200, v193 row_ror:4 row_mask:0xf bank_mask:0x1
  v_mov_b32_dpp v201, v193 row_ror:8 row_mask:0xf bank_mask:0x2
  v_mov_b32_dpp v202, v193 row_ror:12 row_mask:0xf bank_mask:0x4
  v_mov_b32_dpp v203, v193 quad_perm:[0,1,2,3] row_mask:0xf bank_mask:0x8
  s_nop 0
  s_waitcnt vmcnt(15)
  v_mfma_f32_16x16x32_bf16 v[204:207], v[200:203], v[60:63], v[204:207]
  buffer_load_dwordx4 v[124:127], v2, s[12:15], s55 offen nt
  v_mov_b32_dpp v200, v194 quad_perm:[0,1,2,3] row_mask:0xf bank_mask:0x1
  v_mov_b32_dpp v201, v194 row_ror:4 row_mask:0xf bank_mask:0x2
  v_mov_b32_dpp v202, v194 row_ror:8 row_mask:0xf bank_mask:0x4
  v_mov_b32_dpp v203, v194 row_ror:12 row_mask:0xf bank_mask:0x8
  s_nop 0
  s_waitcnt vmcnt(15)
  v_mfma_f32_16x16x32_bf16 v[204:207], v[200:203], v[64:67], v[204:207]
  buffer_load_dwordx4 v[128:131], v2, s[12:15], s56 offen nt
  v_mov_b32_dpp v200, v194 row_ror:12 row_mask:0xf bank_mask:0x1
  v_mov_b32_dpp v201, v194 quad_perm:[0,1,2,3] row_mask:0xf bank_mask:0x2
  v_mov_b32_dpp v202, v194 row_ror:4 row_mask:0xf bank_mask:0x4
  v_mov_b32_dpp v203, v194 row_ror:8 row_mask:0xf bank_mask:0x8
  s_nop 0
  s_waitcnt vmcnt(15)
  v_mfma_f32_16x16x32_bf16 v[204:207], v[200:203], v[68:71], v[204:207]
  buffer_load_dwordx4 v[132:135], v2, s[12:15], s57 offen nt
  v_mov_b32_dpp v200, v194 row_ror:8 row_mask:0xf bank_mask:0x1
  v_mov_b32_dpp v201, v194 row_ror:12 row_mask:0xf bank_mask:0x2
  v_mov_b32_dpp v202, v194 quad_perm:[0,1,2,3] row_mask:0xf bank_mask:0x4
  v_mov_b32_dpp v203, v194 row_ror:4 row_mask:0xf bank_mask:0x8
  s_nop 0
  s_waitcnt vmcnt(15)
  v_mfma_f32_16x16x32_bf16 v[204:207], v[200:203], v[72:75], v[204:207]
  buffer_load_dwordx4 v[136:139], v2, s[12:15], s58 offen nt
  v_mov_b32_dpp v200, v194 row_ror:4 row_mask:0xf bank_mask:0x1
  v_mov_b32_dpp v201, v194 row_ror:8 row_mask:0xf bank_mask:0x2
  v_mov_b32_dpp v202, v194 row_ror:12 row_mask:0xf bank_mask:0x4
  v_mov_b32_dpp v203, v194 quad_perm:[0,1,2,3] row_mask:0xf bank_mask:0x8
  s_nop 0
  s_waitcnt vmcnt(15)
  v_mfma_f32_16x16x32_bf16 v[204:207], v[200:203], v[76:79], v[204:207]
  buffer_load_dwordx4 v[140:143], v2, s[12:15], s59 offen nt
  v_mov_b32_dpp v200, v195 quad_perm:[0,1,2,3] row_mask:0xf bank_mask:0x1
  v_mov_b32_dpp v201, v195 row_ror:4 row_mask:0xf bank_mask:0x2
  v_mov_b32_dpp v202, v195 row_ror:8 row_mask:0xf bank_mask:0x4
  v_mov_b32_dpp v203, v195 row_ror:12 row_mask:0xf bank_mask:0x8
  s_nop 0
  s_waitcnt vmcnt(15)
  v_mfma_f32_16x16x32_bf16 v[204:207], v[200:203], v[80:83], v[204:207]
  buffer_load_dwordx4 v[144:147], v2, s[12:15], s60 offen nt
  v_mov_b32_dpp v200, v195 row_ror:12 row_mask:0xf bank_mask:0x1
  v_mov_b32_dpp v201, v195 quad_perm:[0,1,2,3] row_mask:0xf bank_mask:0x2
  v_mov_b32_dpp v202, v195 row_ror:4 row_mask:0xf bank_mask:0x4
  v_mov_b32_dpp v203, v195 row_ror:8 row_mask:0xf bank_mask:0x8
  s_nop 0
  s_waitcnt vmcnt(15)
  v_mfma_f32_16x16x32_bf16 v[204:207], v[200:203], v[84:87], v[204:207]
  buffer_load_dwordx4 v[148:151], v2, s[12:15], s61 offen nt
  v_mov_b32_dpp v200, v195 row_ror:8 row_mask:0xf bank_mask:0x1
  v_mov_b32_dpp v201, v195 row_ror:12 row_mask:0xf bank_mask:0x2
  v_mov_b32_dpp v202, v195 quad_perm:[0,1,2,3] row_mask:0xf bank_mask:0x4
  v_mov_b32_dpp v203, v195 row_ror:4 row_mask:0xf bank_mask:0x8
  s_nop 0
  s_waitcnt vmcnt(15)
  v_mfma_f32_16x16x32_bf16 v[204:207], v[200:203], v[88:91], v[204:207]
  buffer_load_dwordx4 v[152:155], v2, s[12:15], s62 offen nt
  v_mov_b32_dpp v200, v195 row_ror:4 row_mask:0xf bank_mask:0x1
  v_mov_b32_dpp v201, v195 row_ror:8 row_mask:0xf bank_mask:0x2
  v_mov_b32_dpp v202, v195 row_ror:12 row_mask:0xf bank_mask:0x4
  v_mov_b32_dpp v203, v195 quad_perm:[0,1,2,3] row_mask:0xf bank_mask:0x8
  s_nop 0
  s_waitcnt vmcnt(15)
  v_mfma_f32_16x16x32_bf16 v[204:207], v[200:203], v[92:95], v[204:207]
  buffer_load_dwordx4 v[156:159], v2, s[12:15], s63 offen nt
  v_mov_b32_dpp v200, v196 quad_perm:[0,1,2,3] row_mask:0xf bank_mask:0x1
  v_mov_b32_dpp v201, v196 row_ror:4 row_mask:0xf bank_mask:0x2
  v_mov_b32_dpp v202, v196 row_ror:8 row_mask:0xf bank_mask:0x4
  v_mov_b32_dpp v203, v196 row_ror:12 row_mask:0xf bank_mask:0x8
  s_nop 0
  s_waitcnt vmcnt(15)
  v_mfma_f32_16x16x32_bf16 v[204:207], v[200:203], v[96:99], v[204:207]
  v_mov_b32_dpp v200, v196 row_ror:12 row_mask:0xf bank_mask:0x1
  v_mov_b32_dpp v201, v196 quad_perm:[0,1,2,3] row_mask:0xf bank_mask:0x2
  v_mov_b32_dpp v202, v196 row_ror:4 row_mask:0xf bank_mask:0x4
  v_mov_b32_dpp v203, v196 row_ror:8 row_mask:0xf bank_mask:0x8
  s_nop 0
  s_waitcnt vmcnt(14)
  v_mfma_f32_16x16x32_bf16 v[204:207], v[200:203], v[100:103], v[204:207]
  v_mov_b32_dpp v200, v196 row_ror:8 row_mask:0xf bank_mask:0x1
  v_mov_b32_dpp v201, v196 row_ror:12 row_mask:0xf bank_mask:0x2
  v_mov_b32_dpp v202, v196 quad_perm:[0,1,2,3] row_mask:0xf bank_mask:0x4
  v_mov_b32_dpp v203, v196 row_ror:4 row_mask:0xf bank_mask:0x8
  s_nop 0
  s_waitcnt vmcnt(13)
  v_mfma_f32_16x16x32_bf16 v[204:207], v[200:203], v[104:107], v[204:207]
  v_mov_b32_dpp v200, v196 row_ror:4 row_mask:0xf bank_mask:0x1
  v_mov_b32_dpp v201, v196 row_ror:8 row_mask:0xf bank_mask:0x2
  v_mov_b32_dpp v202, v196 row_ror:12 row_mask:0xf bank_mask:0x4
  v_mov_b32_dpp v203, v196 quad_perm:[0,1,2,3] row_mask:0xf bank_mask:0x8
  s_nop 0
  s_waitcnt vmcnt(12)
  v_mfma_f32_16x16x32_bf16 v[204:207], v[200:203], v[108:111], v[204:207]
  v_mov_b32_dpp v200, v197 quad_perm:[0,1,2,3] row_mask:0xf bank_mask:0x1
  v_mov_b32_dpp v201, v197 row_ror:4 row_mask:0xf bank_mask:0x2
  v_mov_b32_dpp v202, v197 row_ror:8 row_mask:0xf bank_mask:0x4
  v_mov_b32_dpp v203, v197 row_ror:12 row_mask:0xf bank_mask:0x8
  s_nop 0
  s_waitcnt vmcnt(11)
  v_mfma_f32_16x16x32_bf16 v[204:207], v[200:203], v[112:115], v[204:207]
  v_mov_b32_dpp v200, v197 row_ror:12 row_mask:0xf bank_mask:0x1
  v_mov_b32_dpp v201, v197 quad_perm:[0,1,2,3] row_mask:0xf bank_mask:0x2
  v_mov_b32_dpp v202, v197 row_ror:4 row_mask:0xf bank_mask:0x4
  v_mov_b32_dpp v203, v197 row_ror:8 row_mask:0xf bank_mask:0x8
  s_nop 0
  s_waitcnt vmcnt(10)
  v_mfma_f32_16x16x32_bf16 v[204:207], v[200:203], v[116:119], v[204:207]
  v_mov_b32_dpp v200, v197 row_ror:8 row_mask:0xf bank_mask:0x1
  v_mov_b32_dpp v201, v197 row_ror:12 row_mask:0xf bank_mask:0x2
  v_mov_b32_dpp v202, v197 quad_perm:[0,1,2,3] row_mask:0xf bank_mask:0x4
  v_mov_b32_dpp v203, v197 row_ror:4 row_mask:0xf bank_mask:0x8
  s_nop 0
  s_waitcnt vmcnt(9)
  v_mfma_f32_16x16x32_bf16 v[204:207], v[200:203], v[120:123], v[204:207]
  v_mov_b32_dpp v200, v197 row_ror:4 row_mask:0xf bank_mask:0x1
  v_mov_b32_dpp v201, v197 row_ror:8 row_mask:0xf bank_mask:0x2
  v_mov_b32_dpp v202, v197 row_ror:12 row_mask:0xf bank_mask:0x4
  v_mov_b32_dpp v203, v197 quad_perm:[0,1,2,3] row_mask:0xf bank_mask:0x8
  s_nop 0
  s_waitcnt vmcnt(8)
  v_mfma_f32_16x16x32_bf16 v[204:207], v[200:203], v[124:127], v[204:207]
  v_mov_b32_dpp v200, v198 quad_perm:[0,1,2,3] row_mask:0xf bank_mask:0x1
  v_mov_b32_dpp v201, v198 row_ror:4 row_mask:0xf bank_mask:0x2
  v_mov_b32_dpp v202, v198 row_ror:8 row_mask:0xf bank_mask:0x4
  v_mov_b32_dpp v203, v198 row_ror:12 row_mask:0xf bank_mask:0x8
  s_nop 0
  s_waitcnt vmcnt(7)
  v_mfma_f32_16x16x32_bf16 v[204:207], v[200:203], v[128:131], v[204:207]
  v_mov_b32_dpp v200, v198 row_ror:12 row_mask:0xf bank_mask:0x1
  v_mov_b32_dpp v201, v198 quad_perm:[0,1,2,3] row_mask:0xf bank_mask:0x2
  v_mov_b32_dpp v202, v198 row_ror:4 row_mask:0xf bank_mask:0x4
  v_mov_b32_dpp v203, v198 row_ror:8 row_mask:0xf bank_mask:0x8
  s_nop 0
  s_waitcnt vmcnt(6)
  v_mfma_f32_16x16x32_bf16 v[204:207], v[200:203], v[132:135], v[204:207]
  v_mov_b32_dpp v200, v198 row_ror:8 row_mask:0xf bank_mask:0x1
  v_mov_b32_dpp v201, v198 row_ror:12 row_mask:0xf bank_mask:0x2
  v_mov_b32_dpp v202, v198 quad_perm:[0,1,2,3] row_mask:0xf bank_mask:0x4
  v_mov_b32_dpp v203, v198 row_ror:4 row_mask:0xf bank_mask:0x8
  s_nop 0
  s_waitcnt vmcnt(5)
  v_mfma_f32_16x16x32_bf16 v[204:207], v[200:203], v[136:139], v[204:207]
  v_mov_b32_dpp v200, v198 row_ror:4 row_mask:0xf bank_mask:0x1
  v_mov_b32_dpp v201, v198 row_ror:8 row_mask:0xf bank_mask:0x2
  v_mov_b32_dpp v202, v198 row_ror:12 row_mask:0xf bank_mask:0x4
  v_mov_b32_dpp v203, v198 quad_perm:[0,1,2,3] row_mask:0xf bank_mask:0x8
  s_nop 0
  s_waitcnt vmcnt(4)
  v_mfma_f32_16x16x32_bf16 v[204:207], v[200:203], v[140:143], v[204:207]
  v_mov_b32_dpp v200, v199 quad_perm:[0,1,2,3] row_mask:0xf bank_mask:0x1
  v_mov_b32_dpp v201, v199 row_ror:4 row_mask:0xf bank_mask:0x2
  v_mov_b32_dpp v202, v199 row_ror:8 row_mask:0xf bank_mask:0x4
  v_mov_b32_dpp v203, v199 row_ror:12 row_mask:0xf bank_mask:0x8
  s_nop 0
  s_waitcnt vmcnt(3)
  v_mfma_f32_16x16x32_bf16 v[204:207], v[200:203], v[144:147], v[204:207]
  v_mov_b32_dpp v200, v199 row_ror:12 row_mask:0xf bank_mask:0x1
  v_mov_b32_dpp v201, v199 quad_perm:[0,1,2,3] row_mask:0xf bank_mask:0x2
  v_mov_b32_dpp v202, v199 row_ror:4 row_mask:0xf bank_mask:0x4
  v_mov_b32_dpp v203, v199 row_ror:8 row_mask:0xf bank_mask:0x8
  s_nop 0
  s_waitcnt vmcnt(2)
  v_mfma_f32_16x16x32_bf16 v[204:207], v[200:203], v[148:151], v[204:207]
  v_mov_b32_dpp v200, v199 row_ror:8 row_mask:0xf bank_mask:0x1
  v_mov_b32_dpp v201, v199 row_ror:12 row_mask:0xf bank_mask:0x2
  v_mov_b32_dpp v202, v199 quad_perm:[0,1,2,3] row_mask:0xf bank_mask:0x4
  v_mov_b32_dpp v203, v199 row_ror:4 row_mask:0xf bank_mask:0x8
  s_nop 0
  s_waitcnt vmcnt(1)
  v_mfma_f32_16x16x32_bf16 v[204:207], v[200:203], v[152:155], v[204:207]
  v_mov_b32_dpp v200, v199 row_ror:4 row_mask:0xf bank_mask:0x1
  v_mov_b32_dpp v201, v199 row_ror:8 row_mask:0xf bank_mask:0x2
  v_mov_b32_dpp v202, v199 row_ror:12 row_mask:0xf bank_mask:0x4
  v_mov_b32_dpp v203, v199 quad_perm:[0,1,2,3] row_mask:0xf bank_mask:0x8
  s_nop 0
  s_waitcnt vmcnt(0)
  v_mfma_f32_16x16x32_bf16 v[204:207], v[200:203], v[156:159], v[204:207]
  s_nop 7
  v_pk_add_f32 v[204:205], v[204:205], v[206:207]
  ds_write_b64 v13, v[204:205]
  s_waitcnt lgkmcnt(0)
  s_barrier
  s_endpgm
L_helper:
  s_setprio 3
  s_load_dwordx2 s[20:21], s[0:1], 24
  s_load_dwordx2 s[26:27], s[0:1], 40
  v_and_b32 v1, 63, v0
  s_add_u32 s5, s5, 1
  s_and_b32 s5, s5, 7
  s_lshl_b32 s7, s4, 13
  v_mov_b32 v8, s7
  s_add_u32 s7, s7, 0x1000
  v_lshl_add_u32 v5, v1, 4, s7
  s_lshl_b32 s7, s5, 10
  v_add_u32 v6, s7, v5
  v_and_b32 v7, 15, v1
  v_lshlrev_b32 v7, 4, v7
  v_lshrrev_b32 v12, 4, v1
  v_lshl_add_u32 v7, v12, 2, v7
  s_lshl_b32 s7, s4, 8
  v_add_u32 v7, s7, v7
  s_waitcnt lgkmcnt(0)
  global_load_dword v9, v8, s[26:27] sc1
  global_load_dwordx4 v[40:43], v6, s[26:27] offset:-4096 sc1
  v_lshlrev_b32 v3, 3, v1
  v_mov_b32 v4, 0
  v_add_u32 v10, 0x40000, v6
  s_mov_b32 s22, 0
  s_mov_b64 s[24:25], 0
  s_movk_i32 s23, 0xff
  s_mov_b64 exec, 0
  s_branch L_tail
L_mid:
  s_mov_b64 exec, -1
  s_mov_b32 s22, 1
  s_waitcnt vmcnt(0)
  v_add_u32 v9, 0x101, v9
  v_lshrrev_b32 v11, 8, v9
  v_readfirstlane_b32 s24, v9
  s_bfe_u32 s25, s24, 0x80008
  s_and_b32 s24, s24, s23
  s_barrier
L_tail:
  ds_read_b128 v[28:31], v4 offset:2048
  ds_read_b128 v[32:35], v4 offset:2064
  ds_read2st64_b64 v[20:23], v3 offset0:0 offset1:1
  ds_read2st64_b64 v[24:27], v3 offset0:2 offset1:3
  s_cmp_eq_u32 s5, 0
  s_cbranch_scc1 L_early
L_comb:
  s_waitcnt lgkmcnt(2)
  v_max3_f32 v18, v28, v30, v32
  v_max_f32 v18, v18, v34
  v_sub_f32 v28, v28, v18
  v_sub_f32 v30, v30, v18
  v_sub_f32 v32, v32, v18
  v_sub_f32 v34, v34, v18
  v_exp_f32 v28, v28
  v_exp_f32 v30, v30
  v_exp_f32 v32, v32
  v_exp_f32 v34, v34
  s_waitcnt lgkmcnt(0)
  v_pk_mul_f32 v[16:17], v[20:21], v[28:29] op_sel:[0,0] op_sel_hi:[1,0]
  v_mul_f32 v19, v29, v28
  v_pk_fma_f32 v[16:17], v[22:23], v[30:31], v[16:17] op_sel:[0,0,0] op_sel_hi:[1,0,1]
  v_fmac_f32 v19, v31, v30
  v_pk_fma_f32 v[16:17], v[24:25], v[32:33], v[16:17] op_sel:[0,0,0] op_sel_hi:[1,0,1]
  v_fmac_f32 v19, v33, v32
  v_pk_fma_f32 v[16:17], v[26:27], v[34:35], v[16:17] op_sel:[0,0,0] op_sel_hi:[1,0,1]
  v_fmac_f32 v19, v35, v34
  s_cbranch_scc1 L_cons
  v_bfi_b32 v16, s23, v9, v16
  v_bfi_b32 v19, s23, v11, v19
  global_store_dwordx4 v6, v[16:19], s[26:27] offset:-4096
  global_store_dwordx4 v10, v[16:19], s[26:27] offset:-4096 sc1
  s_cmp_lg_u32 s22, 0
  s_cbranch_scc0 L_mid
  s_endpgm
L_early:
  global_load_dwordx4 v[40:43], v5, s[26:27] offset:-3072 sc1
  global_load_dwordx4 v[44:47], v5, s[26:27] offset:-2048 sc1
  global_load_dwordx4 v[48:51], v5, s[26:27] offset:-1024 sc1
  global_load_dwordx4 v[52:55], v5, s[26:27] offset:0 sc1
  global_load_dwordx4 v[56:59], v5, s[26:27] offset:1024 sc1
  global_load_dwordx4 v[60:63], v5, s[26:27] offset:2048 sc1
  global_load_dwordx4 v[64:67], v5, s[26:27] offset:3072 sc1
  s_mov_b32 s6, 0
  s_branch L_comb
L_poll:
  global_load_dwordx4 v[40:43], v5, s[26:27] offset:-3072 sc1
  global_load_dwordx4 v[44:47], v5, s[26:27] offset:-2048 sc1
  global_load_dwordx4 v[48:51], v5, s[26:27] offset:-1024 sc1
  global_load_dwordx4 v[52:55], v5, s[26:27] offset:0 sc1
  global_load_dwordx4 v[56:59], v5, s[26:27] offset:1024 sc1
  global_load_dwordx4 v[60:63], v5, s[26:27] offset:2048 sc1
  global_load_dwordx4 v[64:67], v5, s[26:27] offset:3072 sc1
L_cons:
  s_add_u32 s6, s6, 1
  s_waitcnt vmcnt(6)
  v_xor_b32 v40, s24, v40
  v_xor_b32 v43, s25, v43
  v_or_b32 v20, v40, v43
  s_waitcnt vmcnt(5)
  v_xor_b32 v44, s24, v44
  v_xor_b32 v47, s25, v47
  v_or3_b32 v20, v20, v44, v47
  s_waitcnt vmcnt(4)
  v_xor_b32 v48, s24, v48
  v_xor_b32 v51, s25, v51
  v_or3_b32 v20, v20, v48, v51
  s_waitcnt vmcnt(3)
  v_xor_b32 v52, s24, v52
  v_xor_b32 v55, s25, v55
  v_or3_b32 v20, v20, v52, v55
  s_waitcnt vmcnt(2)
  v_xor_b32 v56, s24, v56
  v_xor_b32 v59, s25, v59
  v_or3_b32 v20, v20, v56, v59
  s_waitcnt vmcnt(1)
  v_xor_b32 v60, s24, v60
  v_xor_b32 v63, s25, v63
  v_or3_b32 v20, v20, v60, v63
  s_waitcnt vmcnt(0)
  v_xor_b32 v64, s24, v64
  v_xor_b32 v67, s25, v67
  v_or3_b32 v20, v20, v64, v67
  v_and_b32 v20, s23, v20
  v_cmp_ne_u32 vcc, 0, v20
  s_cbranch_vccnz L_retry
  v_max3_f32 v20, v42, v46, v50
  v_max3_f32 v21, v54, v58, v62
  v_max3_f32 v20, v20, v66, v18
  v_max_f32 v20, v20, v21
  v_sub_f32 v18, v18, v20
  v_sub_f32 v42, v42, v20
  v_sub_f32 v46, v46, v20
  v_sub_f32 v50, v50, v20
  v_sub_f32 v54, v54, v20
  v_sub_f32 v58, v58, v20
  v_sub_f32 v62, v62, v20
  v_sub_f32 v66, v66, v20
  v_exp_f32 v18, v18
  v_exp_f32 v42, v42
  v_exp_f32 v46, v46
  v_exp_f32 v50, v50
  v_exp_f32 v54, v54
  v_exp_f32 v58, v58
  v_exp_f32 v62, v62
  v_exp_f32 v66, v66
  v_mul_f32 v26, v19, v18
  v_fmac_f32 v26, v43, v42
  v_fmac_f32 v26, v47, v46
  v_fmac_f32 v26, v51, v50
  v_fmac_f32 v26, v55, v54
  v_fmac_f32 v26, v59, v58
  v_fmac_f32 v26, v63, v62
  v_fmac_f32 v26, v67, v66
  v_pk_mul_f32 v[24:25], v[16:17], v[18:19] op_sel:[0,0] op_sel_hi:[1,0]
  v_rcp_f32 v26, v26
  v_pk_fma_f32 v[24:25], v[40:41], v[42:43], v[24:25] op_sel:[0,0,0] op_sel_hi:[1,0,1]
  v_pk_fma_f32 v[24:25], v[44:45], v[46:47], v[24:25] op_sel:[0,0,0] op_sel_hi:[1,0,1]
  v_pk_fma_f32 v[24:25], v[48:49], v[50:51], v[24:25] op_sel:[0,0,0] op_sel_hi:[1,0,1]
  v_pk_fma_f32 v[24:25], v[52:53], v[54:55], v[24:25] op_sel:[0,0,0] op_sel_hi:[1,0,1]
  v_pk_fma_f32 v[24:25], v[56:57], v[58:59], v[24:25] op_sel:[0,0,0] op_sel_hi:[1,0,1]
  v_pk_fma_f32 v[24:25], v[60:61], v[62:63], v[24:25] op_sel:[0,0,0] op_sel_hi:[1,0,1]
  v_pk_fma_f32 v[24:25], v[64:65], v[66:67], v[24:25] op_sel:[0,0,0] op_sel_hi:[1,0,1]
  v_pk_mul_f32 v[24:25], v[24:25], v[26:27] op_sel:[0,0] op_sel_hi:[1,0]
  v_cvt_pk_bf16_f32 v24, v24, v25
  global_store_dword v7, v24, s[20:21]
  global_store_dword v8, v9, s[26:27]
  s_cmp_lg_u32 s22, 0
  s_cbranch_scc0 L_mid
  s_endpgm
L_retry:
  s_cmp_lt_u32 s6, 16
  s_cbranch_scc1 L_poll
  v_xor_b32 v5, 0x40000, v5
  s_cmp_lt_u32 s6, 0x200000
  s_cbranch_scc1 L_poll
L_end:
L_exit:
  s_endpgm
L_pad:
  .fill (5248 - (L_pad - standalone__softmax_full_bidir__decode_kernel)) / 4, 4, 0xbf810000
.section .rodata,"a"
.p2align 6
.amdhsa_kernel standalone__softmax_full_bidir__decode_kernel
  .amdhsa_next_free_vgpr 212
  .amdhsa_next_free_sgpr 72
  .amdhsa_accum_offset 212
  .amdhsa_group_segment_fixed_size 0
  .amdhsa_kernarg_size 48
  .amdhsa_user_sgpr_count 2
  .amdhsa_user_sgpr_kernarg_segment_ptr 1
  .amdhsa_system_sgpr_workgroup_id_x 1
.end_amdhsa_kernel
```
